```python
import torch

def _softmax(x, axis=-1):
    return torch.softmax(x, dim=axis)
def _gelu(x):
    return torch.nn.functional.gelu(x, approximate="tanh")
def _silu(x):
    return torch.nn.functional.silu(x)
def _sigmoid(x):
    return torch.sigmoid(x)
def _layernorm(x, axis=-1, eps=1e-5):
    m = x.mean(dim=axis, keepdim=True)
    v = x.var(dim=axis, keepdim=True, unbiased=False)
    return (x - m) / torch.sqrt(v + eps)
def _scatter_add(tgt, idx, src, axis=0):
    return tgt.clone().index_add_(axis, idx, src)
def _segment_sum(src, seg, n):
    out = torch.zeros((n,) + src.shape[1:], dtype=src.dtype)
    return out.index_add_(0, seg, src)
def _pad(x, pw):
    flat = tuple(v for pair in reversed(pw) for v in pair)
    return torch.nn.functional.pad(x, flat)

kernel_name = 'standalone__linear_kernel_rfa__prompt'

def setup_inputs():

    _w = (lambda a: (lambda t: t.to(torch.bfloat16) if t.is_floating_point() else t)(torch.as_tensor(a)))
    B, H, Sq, Sk, D, M = 1, 32, 2048, 2048, 192, 8
    return {
        "q": _w((lambda *s: torch.randn(*s, dtype=torch.bfloat16) * 0.05)(B, H, Sq, D)),
        "k": _w((lambda *s: torch.randn(*s, dtype=torch.bfloat16) * 0.4)(B, H, Sk, D)),
        "v": _w((lambda *s: torch.randn(*s, dtype=torch.bfloat16) * 0.4)(B, H, Sk, D)),
        "omega": _w((lambda *s: torch.randn(*s, dtype=torch.bfloat16) * 0.8)(M, D)),
    }

def reference(q, k, v, omega):
    d = q.shape[-1]
    m = omega.shape[0]
    scale = float(d) ** -0.25
    qs = q * scale
    ks = k * scale
    q_proj = torch.einsum("bhsd,md->bhsm", qs, omega)
    k_proj = torch.einsum("bhsd,md->bhsm", ks, omega)
    q_sq = 0.5 * torch.einsum("bhsd,bhsd->bhs", qs, qs)[..., None]
    k_sq = 0.5 * torch.einsum("bhsd,bhsd->bhs", ks, ks)[..., None]
    inv_sqrt_m = float(m) ** -0.5
    phi_q = torch.exp(q_proj - q_sq) * inv_sqrt_m + 1e-6
    phi_k = torch.exp(k_proj - k_sq) * inv_sqrt_m + 1e-6
    kv = torch.einsum("bhsm,bhsd->bhmd", phi_k, v)
    z  = torch.einsum("bhsm->bhm", phi_k)
    num = torch.einsum("bhqm,bhmd->bhqd", phi_q, kv)
    den = torch.einsum("bhqm,bhm->bhq", phi_q, z)[..., None] + 1e-6
    return num / den
```

```asm
; @launch grid=(256,1,1) block=(512,1,1) lds=158336
.amdgcn_target "amdgcn-amd-amdhsa--gfx950"
.text
.globl standalone__linear_kernel_rfa__prompt_kernel
.p2align 8
.type standalone__linear_kernel_rfa__prompt_kernel,@function
standalone__linear_kernel_rfa__prompt_kernel:
    s_cmp_ge_u32 s2, 256
    s_cbranch_scc1 L_end
    s_load_dwordx2 s[20:21], s[0:1], 8
    s_getpc_b64 s[92:93]
L_pc:
    v_lshlrev_b32 v16, 7, v0
    v_min_u32 v16, L_end-L_pc, v16
    v_mov_b32 v17, s93
    v_add_co_u32 v16, vcc, s92, v16
    s_nop 1
    v_addc_co_u32 v17, vcc, 0, v17, vcc
    v_cmp_gt_u32 vcc, 64, v0
    s_nop 0
    s_and_saveexec_b64 s[94:95], vcc
    s_cbranch_execz L_nocpf
    global_load_dword v254, v[16:17], off
L_nocpf:
    s_mov_b64 exec, s[94:95]
    v_and_b32 v1, 63, v0
    v_lshrrev_b32 v8, 6, v0
    v_add_u32 v12, 16, v1
    v_readfirstlane_b32 s18, v8
    v_lshlrev_b32 v11, 4, v1
    v_lshrrev_b32 v12, 2, v12
    v_and_b32 v12, 16, v12
    v_xor_b32 v128, v11, v12
    s_and_b32 s57, s2, 7
    s_lshr_b32 s58, s2, 6
    s_lshl_b32 s58, s58, 3
    s_or_b32 s53, s57, s58
    s_bfe_u32 s54, s2, 0x30003
    s_mul_i32 s57, s53, 786432
    s_mul_i32 s58, s54, 98304
    s_add_u32 s57, s57, s58
    s_mul_i32 s101, s18, 12288
    s_add_u32 s48, s57, s101
    s_add_u32 s101, s101, 60032
    s_mov_b32 s22, 0x1800000
    s_mov_b32 s23, 0x20000
    s_mov_b32 m0, s101
    s_setprio 3
    s_waitcnt lgkmcnt(0)
    buffer_load_dwordx4 v128, s[20:23], s48 offen offset:0 nt lds
    s_load_dwordx2 s[28:29], s[0:1], 24
    s_load_dwordx2 s[24:25], s[0:1], 16
    s_load_dwordx2 s[32:33], s[0:1], 48
    s_load_dwordx2 s[44:45], s[0:1], 40
    s_load_dwordx2 s[36:37], s[0:1], 0
    s_load_dwordx2 s[40:41], s[0:1], 32
    v_lshrrev_b32 v13, 1, v1
    v_and_b32 v13, 16, v13
    v_add_u32 v14, 16, v13
    v_xor_b32 v129, v11, v14
    buffer_load_dwordx4 v129, s[20:23], s48 offen offset:1024 nt lds
    v_add_u32 v15, 48, v1
    v_lshrrev_b32 v15, 2, v15
    v_and_b32 v15, 16, v15
    v_add_u32 v14, 32, v15
    v_xor_b32 v130, v11, v14
    buffer_load_dwordx4 v130, s[20:23], s48 offen offset:2048 nt lds
    v_add_u32 v14, 64, v12
    v_xor_b32 v131, v11, v14
    buffer_load_dwordx4 v131, s[20:23], s48 offen offset:3072 nt lds
    v_add_u32 v14, 80, v13
    s_add_u32 s99, s48, 4096
    s_add_u32 m0, s101, 4096
    v_xor_b32 v132, v11, v14
    buffer_load_dwordx4 v132, s[20:23], s99 offen offset:0 nt lds
    v_add_u32 v14, 96, v15
    s_add_u32 s49, s48, 6144
    v_xor_b32 v133, v11, v14
    buffer_load_dwordx4 v133, s[20:23], s99 offen offset:1024 nt lds
    s_add_u32 s100, s49, 4096
    s_mul_i32 s19, s18, 6656
    s_add_u32 s19, s19, 6784
    s_or_b32 s3, s53, s54
    s_or_b32 s3, s3, s18
    s_mov_b32 s30, 0xc00
    s_mov_b32 s31, 0x20000
    s_mov_b32 s26, 0x1800000
    s_mov_b32 s27, 0x20000
    s_mov_b32 s34, 0x10000000
    s_mov_b32 s35, 0x20000
    s_mov_b32 s46, 0x100
    s_mov_b32 s47, 0x20000
    s_mov_b32 s38, 0x1800000
    s_mov_b32 s39, 0x20000
    s_mov_b32 s42, 0x1800000
    s_mov_b32 s43, 0x20000
    s_waitcnt lgkmcnt(0)
    v_mov_b32 v244, 0
    v_and_b32 v9, 15, v0
    v_bfe_u32 v10, v0, 4, 2
    s_getreg_b32 s57, hwreg(HW_REG_XCC_ID, 0, 3)
    s_lshl_b32 s57, 1, s57
    s_and_b32 s58, s57, 0x55
    s_cbranch_scc1 L_thr12
    s_mov_b32 m0, s19
    s_nop 0
    buffer_load_dwordx4 v128, s[28:31], 0 offen offset:0 lds
    buffer_load_dwordx4 v129, s[28:31], 0 offen offset:1024 lds
    buffer_load_dwordx4 v130, s[28:31], 0 offen offset:2048 lds
    s_cmp_lg_u32 s3, 0
    s_cbranch_scc1 L_nochooseL0
    buffer_load_dword v248, v244, s[32:35], 0 offen sc1
L_nochooseL0:
    s_add_u32 m0, s101, 6144
    s_nop 0
    buffer_load_dwordx4 v128, s[20:23], s49 offen offset:0 nt lds
    buffer_load_dwordx4 v129, s[20:23], s49 offen offset:1024 nt lds
    buffer_load_dwordx4 v130, s[20:23], s49 offen offset:2048 nt lds
    buffer_load_dwordx4 v131, s[20:23], s49 offen offset:3072 nt lds
    s_add_u32 m0, s101, 10240
    s_nop 0
    buffer_load_dwordx4 v132, s[20:23], s100 offen offset:0 nt lds
    buffer_load_dwordx4 v133, s[20:23], s100 offen offset:1024 nt lds
    v_mul_u32_u24 v13, 1536, v10
    v_lshlrev_b32 v14, 4, v9
    v_add_u32 v3, v13, v14
    v_lshlrev_b32 v14, 3, v9
    v_add_u32 v13, 256, v13
    v_add_u32 v4, v13, v14
    buffer_load_dwordx4 v[80:83], v3, s[24:27], s48 offen offset:0 nt
    buffer_load_dwordx2 v[112:113], v4, s[24:27], s48 offen offset:0 nt
    buffer_load_dwordx4 v[84:87], v3, s[24:27], s48 offen offset:384 nt
    buffer_load_dwordx2 v[114:115], v4, s[24:27], s48 offen offset:384 nt
    buffer_load_dwordx4 v[88:91], v3, s[24:27], s48 offen offset:768 nt
    buffer_load_dwordx2 v[116:117], v4, s[24:27], s48 offen offset:768 nt
    buffer_load_dwordx4 v[92:95], v3, s[24:27], s48 offen offset:1152 nt
    buffer_load_dwordx2 v[118:119], v4, s[24:27], s48 offen offset:1152 nt
    buffer_load_dwordx4 v[96:99], v3, s[24:27], s49 offen offset:0 nt
    buffer_load_dwordx2 v[120:121], v4, s[24:27], s49 offen offset:0 nt
    buffer_load_dwordx4 v[100:103], v3, s[24:27], s49 offen offset:384 nt
    buffer_load_dwordx2 v[122:123], v4, s[24:27], s49 offen offset:384 nt
    buffer_load_dwordx4 v[104:107], v3, s[24:27], s49 offen offset:768 nt
    buffer_load_dwordx2 v[124:125], v4, s[24:27], s49 offen offset:768 nt
    buffer_load_dwordx4 v[108:111], v3, s[24:27], s49 offen offset:1152 nt
    buffer_load_dwordx2 v[126:127], v4, s[24:27], s49 offen offset:1152 nt
    s_branch L_kvdone
L_thr12:
    s_mov_b32 m0, s19
    s_nop 0
    buffer_load_dwordx4 v128, s[28:31], 0 offen offset:0 lds
    buffer_load_dwordx4 v129, s[28:31], 0 offen offset:1024 lds
    buffer_load_dwordx4 v130, s[28:31], 0 offen offset:2048 lds
    s_cmp_lg_u32 s3, 0
    s_cbranch_scc1 L_nochooseL12
    buffer_load_dword v248, v244, s[32:35], 0 offen sc1
L_nochooseL12:
    s_add_u32 m0, s101, 6144
    s_nop 0
    buffer_load_dwordx4 v128, s[20:23], s49 offen offset:0 nt lds
    buffer_load_dwordx4 v129, s[20:23], s49 offen offset:1024 nt lds
    buffer_load_dwordx4 v130, s[20:23], s49 offen offset:2048 nt lds
    s_waitcnt vmcnt(11)
    buffer_load_dwordx4 v131, s[20:23], s49 offen offset:3072 nt lds
    s_waitcnt vmcnt(11)
    s_add_u32 m0, s101, 10240
    s_nop 0
    buffer_load_dwordx4 v132, s[20:23], s100 offen offset:0 nt lds
    s_waitcnt vmcnt(11)
    buffer_load_dwordx4 v133, s[20:23], s100 offen offset:1024 nt lds
    s_waitcnt vmcnt(11)
    v_mul_u32_u24 v13, 1536, v10
    v_lshlrev_b32 v14, 4, v9
    v_add_u32 v3, v13, v14
    v_lshlrev_b32 v14, 3, v9
    v_add_u32 v13, 256, v13
    v_add_u32 v4, v13, v14
    buffer_load_dwordx4 v[80:83], v3, s[24:27], s48 offen offset:0 nt
    s_waitcnt vmcnt(11)
    buffer_load_dwordx2 v[112:113], v4, s[24:27], s48 offen offset:0 nt
    s_waitcnt vmcnt(11)
    buffer_load_dwordx4 v[84:87], v3, s[24:27], s48 offen offset:384 nt
    s_waitcnt vmcnt(11)
    buffer_load_dwordx2 v[114:115], v4, s[24:27], s48 offen offset:384 nt
    s_waitcnt vmcnt(11)
    buffer_load_dwordx4 v[88:91], v3, s[24:27], s48 offen offset:768 nt
    s_waitcnt vmcnt(11)
    buffer_load_dwordx2 v[116:117], v4, s[24:27], s48 offen offset:768 nt
    s_waitcnt vmcnt(11)
    buffer_load_dwordx4 v[92:95], v3, s[24:27], s48 offen offset:1152 nt
    s_waitcnt vmcnt(11)
    buffer_load_dwordx2 v[118:119], v4, s[24:27], s48 offen offset:1152 nt
    s_waitcnt vmcnt(11)
    buffer_load_dwordx4 v[96:99], v3, s[24:27], s49 offen offset:0 nt
    s_waitcnt vmcnt(11)
    buffer_load_dwordx2 v[120:121], v4, s[24:27], s49 offen offset:0 nt
    s_waitcnt vmcnt(11)
    buffer_load_dwordx4 v[100:103], v3, s[24:27], s49 offen offset:384 nt
    s_waitcnt vmcnt(11)
    buffer_load_dwordx2 v[122:123], v4, s[24:27], s49 offen offset:384 nt
    s_waitcnt vmcnt(11)
    buffer_load_dwordx4 v[104:107], v3, s[24:27], s49 offen offset:768 nt
    s_waitcnt vmcnt(11)
    buffer_load_dwordx2 v[124:125], v4, s[24:27], s49 offen offset:768 nt
    s_waitcnt vmcnt(11)
    buffer_load_dwordx4 v[108:111], v3, s[24:27], s49 offen offset:1152 nt
    s_waitcnt vmcnt(11)
    buffer_load_dwordx2 v[126:127], v4, s[24:27], s49 offen offset:1152 nt
    s_waitcnt vmcnt(11)
L_kvdone:
    s_cmp_lg_u32 s18, 4
    s_cbranch_scc1 L_issued
    buffer_load_dword v245, v244, s[44:47], 0 offen sc1
L_issued:
    s_setprio 0
    s_mul_i32 s56, s53, 53248
    s_mul_i32 s58, s54, 6656
    s_add_u32 s55, s56, s58
    s_mov_b32 s50, 0x05040100
    s_mov_b32 s51, 0x07060302
    s_mov_b32 s52, 0x3ec66f78
    s_mov_b32 s61, 0xfffff000
    v_mov_b32 v6, 0xbe098b82
    v_mov_b32 v7, 0xbfc00000
    v_lshrrev_b32 v11, 1, v9
    v_mul_u32_u24 v12, 384, v9
    v_add_u32 v12, s101, v12
    v_xor_b32 v13, v10, v11
    v_lshl_add_u32 v2, v13, 4, v12
    v_xor_b32 v13, 4, v13
    v_lshl_add_u32 v5, v13, 4, v12
    v_and_b32 v9, 7, v9
    v_lshrrev_b32 v11, 1, v9
    v_mul_u32_u24 v12, 384, v9
    v_add_u32 v12, s19, v12
    v_xor_b32 v13, v10, v11
    v_lshl_add_u32 v134, v13, 4, v12
    v_xor_b32 v13, 4, v13
    v_lshl_add_u32 v135, v13, 4, v12
    s_cmp_eq_u32 s18, 4
    s_cbranch_scc1 L_w4_k0
    s_waitcnt vmcnt(22)
    s_branch L_wd_k0
L_w4_k0:
    s_waitcnt vmcnt(23)
L_wd_k0:
    ds_read_b128 v[8:11], v134 offset:0
    ds_read_b128 v[12:15], v135 offset:0
    ds_read_b128 v[16:19], v134 offset:128
    ds_read_b128 v[20:23], v135 offset:128
    ds_read_b128 v[24:27], v134 offset:256
    ds_read_b128 v[28:31], v135 offset:256
    ds_read_b128 v[32:35], v2 offset:0
    ds_read_b128 v[36:39], v5 offset:0
    ds_read_b128 v[40:43], v2 offset:128
    ds_read_b128 v[44:47], v5 offset:128
    ds_read_b128 v[48:51], v2 offset:256
    ds_read_b128 v[52:55], v5 offset:256
    s_cmp_eq_u32 s18, 4
    s_cbranch_scc1 L_w4_k1
    s_waitcnt vmcnt(16)
    s_branch L_wd_k1
L_w4_k1:
    s_waitcnt vmcnt(17)
L_wd_k1:
    s_cmp_lg_u32 s3, 0
    s_cbranch_scc1 L_notchooser
    s_setprio 3
    v_add_u32 v248, 1, v248
    v_and_b32 v248, 0xfff, v248
    v_or_b32 v248, 0x80000000, v248
    s_mov_b64 exec, 1
    buffer_store_dword v248, v244, s[44:47], 0 offen sc1
    s_mov_b64 exec, -1
    s_setprio 0
L_notchooser:
    s_waitcnt lgkmcnt(6)
    ds_read_b128 v[56:59], v2 offset:6144
    ds_read_b128 v[60:63], v5 offset:6144
    ds_read_b128 v[64:67], v2 offset:6272
    ds_read_b128 v[68:71], v5 offset:6272
    ds_read_b128 v[72:75], v2 offset:6400
    ds_read_b128 v[76:79], v5 offset:6400
    s_waitcnt lgkmcnt(6)
    v_mov_b32 v236, 0
    v_mov_b32 v237, 0
    v_mfma_f32_16x16x32_bf16 v[228:231], v[32:35], v[8:11], 0
    v_dot2c_f32_bf16 v236, v32, v32
    v_dot2c_f32_bf16 v237, v33, v33
    v_dot2c_f32_bf16 v236, v34, v34
    v_dot2c_f32_bf16 v237, v35, v35
    v_mfma_f32_16x16x32_bf16 v[228:231], v[36:39], v[12:15], v[228:231]
    v_dot2c_f32_bf16 v236, v36, v36
    v_dot2c_f32_bf16 v237, v37, v37
    v_dot2c_f32_bf16 v236, v38, v38
    v_dot2c_f32_bf16 v237, v39, v39
    v_mfma_f32_16x16x32_bf16 v[228:231], v[40:43], v[16:19], v[228:231]
    v_dot2c_f32_bf16 v236, v40, v40
    v_dot2c_f32_bf16 v237, v41, v41
    v_dot2c_f32_bf16 v236, v42, v42
    v_dot2c_f32_bf16 v237, v43, v43
    v_mfma_f32_16x16x32_bf16 v[228:231], v[44:47], v[20:23], v[228:231]
    v_dot2c_f32_bf16 v236, v44, v44
    v_dot2c_f32_bf16 v237, v45, v45
    v_dot2c_f32_bf16 v236, v46, v46
    v_dot2c_f32_bf16 v237, v47, v47
    v_mfma_f32_16x16x32_bf16 v[228:231], v[48:51], v[24:27], v[228:231]
    v_dot2c_f32_bf16 v236, v48, v48
    v_dot2c_f32_bf16 v237, v49, v49
    v_dot2c_f32_bf16 v236, v50, v50
    v_dot2c_f32_bf16 v237, v51, v51
    v_mfma_f32_16x16x32_bf16 v[228:231], v[52:55], v[28:31], v[228:231]
    v_dot2c_f32_bf16 v236, v52, v52
    v_dot2c_f32_bf16 v237, v53, v53
    v_dot2c_f32_bf16 v236, v54, v54
    v_dot2c_f32_bf16 v237, v55, v55
    s_nop 2
    v_add_f32 v236, v236, v237
    s_nop 1
    v_mfma_f32_16x16x4_f32 v[228:231], v236, v6, v[228:231]
    s_waitcnt lgkmcnt(0)
    v_mov_b32 v238, 0
    v_mov_b32 v239, 0
    v_mfma_f32_16x16x32_bf16 v[232:235], v[56:59], v[8:11], 0
    v_dot2c_f32_bf16 v238, v56, v56
    v_dot2c_f32_bf16 v239, v57, v57
    v_dot2c_f32_bf16 v238, v58, v58
    v_dot2c_f32_bf16 v239, v59, v59
    v_mfma_f32_16x16x32_bf16 v[232:235], v[60:63], v[12:15], v[232:235]
    v_dot2c_f32_bf16 v238, v60, v60
    v_dot2c_f32_bf16 v239, v61, v61
    v_dot2c_f32_bf16 v238, v62, v62
    v_dot2c_f32_bf16 v239, v63, v63
    v_mfma_f32_16x16x32_bf16 v[232:235], v[64:67], v[16:19], v[232:235]
    v_dot2c_f32_bf16 v238, v64, v64
    v_dot2c_f32_bf16 v239, v65, v65
    v_dot2c_f32_bf16 v238, v66, v66
    v_dot2c_f32_bf16 v239, v67, v67
    v_mfma_f32_16x16x32_bf16 v[232:235], v[68:71], v[20:23], v[232:235]
    v_dot2c_f32_bf16 v238, v68, v68
    v_dot2c_f32_bf16 v239, v69, v69
    v_dot2c_f32_bf16 v238, v70, v70
    v_dot2c_f32_bf16 v239, v71, v71
    v_mfma_f32_16x16x32_bf16 v[232:235], v[72:75], v[24:27], v[232:235]
    v_dot2c_f32_bf16 v238, v72, v72
    v_dot2c_f32_bf16 v239, v73, v73
    v_dot2c_f32_bf16 v238, v74, v74
    v_dot2c_f32_bf16 v239, v75, v75
    v_mfma_f32_16x16x32_bf16 v[232:235], v[76:79], v[28:31], v[232:235]
    v_dot2c_f32_bf16 v238, v76, v76
    v_dot2c_f32_bf16 v239, v77, v77
    v_dot2c_f32_bf16 v238, v78, v78
    v_dot2c_f32_bf16 v239, v79, v79
    s_nop 2
    v_add_f32 v238, v238, v239
    s_nop 1
    v_mfma_f32_16x16x4_f32 v[232:235], v238, v6, v[232:235]
    v_fma_f32 v228, v228, s52, v7
    v_fma_f32 v229, v229, s52, v7
    v_fma_f32 v230, v230, s52, v7
    v_fma_f32 v231, v231, s52, v7
    v_exp_f32 v228, v228
    v_exp_f32 v229, v229
    v_exp_f32 v230, v230
    v_exp_f32 v231, v231
    v_add_f32 v228, 0x358637bd, v228
    v_add_f32 v229, 0x358637bd, v229
    v_add_f32 v230, 0x358637bd, v230
    v_add_f32 v231, 0x358637bd, v231
    v_fma_f32 v232, v232, s52, v7
    v_fma_f32 v233, v233, s52, v7
    v_fma_f32 v234, v234, s52, v7
    v_fma_f32 v235, v235, s52, v7
    v_exp_f32 v232, v232
    v_exp_f32 v233, v233
    v_exp_f32 v234, v234
    v_exp_f32 v235, v235
    v_add_f32 v232, 0x358637bd, v232
    v_add_f32 v233, 0x358637bd, v233
    v_add_f32 v234, 0x358637bd, v234
    v_add_f32 v235, 0x358637bd, v235
    v_cvt_pk_bf16_f32 v240, v228, v229
    v_cvt_pk_bf16_f32 v241, v230, v231
    v_cvt_pk_bf16_f32 v242, v232, v233
    v_cvt_pk_bf16_f32 v243, v234, v235
    s_waitcnt vmcnt(0)
    s_cmp_lt_u32 s18, 4
    s_cbranch_scc1 L_vready
    s_setprio 3
    s_cmp_lg_u32 s18, 4
    s_cbranch_scc1 L_vready
    v_readfirstlane_b32 s67, v245
    s_nop 0
    s_cmp_lt_i32 s67, 0
    s_cbranch_scc1 L_tagput
    s_mov_b32 s59, 0x4000
L_tagspin:
    buffer_load_dword v245, v244, s[44:47], 0 offen sc1
    s_waitcnt vmcnt(0)
    v_readfirstlane_b32 s67, v245
    s_sub_u32 s59, s59, 1
    s_cmp_eq_u32 s59, 0
    s_cbranch_scc1 L_tagput
    s_cmp_ge_i32 s67, 0
    s_cbranch_scc1 L_tagspin
L_tagput:
    s_and_b32 s67, s67, 0xfff
    v_mov_b32 v245, s67
    v_mov_b32 v244, 6656
    ds_write_b32 v244, v245
L_vready:
    v_mov_b32 v252, 0x3f803f80
    v_mov_b32 v253, 0x3f803f80
    v_mov_b32 v254, 0x3f803f80
    v_mov_b32 v255, 0x3f803f80
    s_nop 1
    v_mfma_f32_16x16x32_bf16 v[224:227], v[240:243], v[252:255], 0
    v_perm_b32 v244, v84, v80, s50
    v_perm_b32 v245, v92, v88, s50
    v_perm_b32 v246, v100, v96, s50
    v_perm_b32 v247, v108, v104, s50
    s_nop 1
    v_mfma_f32_16x16x32_bf16 v[176:179], v[240:243], v[244:247], 0
    v_perm_b32 v248, v84, v80, s51
    v_perm_b32 v249, v92, v88, s51
    v_perm_b32 v250, v100, v96, s51
    v_perm_b32 v251, v108, v104, s51
    s_nop 1
    v_mfma_f32_16x16x32_bf16 v[180:183], v[240:243], v[248:251], 0
    v_perm_b32 v244, v85, v81, s50
    v_perm_b32 v245, v93, v89, s50
    v_perm_b32 v246, v101, v97, s50
    v_perm_b32 v247, v109, v105, s50
    s_nop 1
    v_mfma_f32_16x16x32_bf16 v[184:187], v[240:243], v[244:247], 0
    v_perm_b32 v248, v85, v81, s51
    v_perm_b32 v249, v93, v89, s51
    v_perm_b32 v250, v101, v97, s51
    v_perm_b32 v251, v109, v105, s51
    s_nop 1
    v_mfma_f32_16x16x32_bf16 v[188:191], v[240:243], v[248:251], 0
    v_perm_b32 v244, v86, v82, s50
    v_perm_b32 v245, v94, v90, s50
    v_perm_b32 v246, v102, v98, s50
    v_perm_b32 v247, v110, v106, s50
    s_nop 1
    v_mfma_f32_16x16x32_bf16 v[192:195], v[240:243], v[244:247], 0
    v_perm_b32 v248, v86, v82, s51
    v_perm_b32 v249, v94, v90, s51
    v_perm_b32 v250, v102, v98, s51
    v_perm_b32 v251, v110, v106, s51
    s_nop 1
    v_mfma_f32_16x16x32_bf16 v[196:199], v[240:243], v[248:251], 0
    v_perm_b32 v244, v87, v83, s50
    v_perm_b32 v245, v95, v91, s50
    v_perm_b32 v246, v103, v99, s50
    v_perm_b32 v247, v111, v107, s50
    s_nop 1
    v_mfma_f32_16x16x32_bf16 v[200:203], v[240:243], v[244:247], 0
    v_perm_b32 v248, v87, v83, s51
    v_perm_b32 v249, v95, v91, s51
    v_perm_b32 v250, v103, v99, s51
    v_perm_b32 v251, v111, v107, s51
    s_nop 1
    v_mfma_f32_16x16x32_bf16 v[204:207], v[240:243], v[248:251], 0
    v_perm_b32 v244, v114, v112, s50
    v_perm_b32 v245, v118, v116, s50
    v_perm_b32 v246, v122, v120, s50
    v_perm_b32 v247, v126, v124, s50
    s_nop 1
    v_mfma_f32_16x16x32_bf16 v[208:211], v[240:243], v[244:247], 0
    v_perm_b32 v248, v114, v112, s51
    v_perm_b32 v249, v118, v116, s51
    v_perm_b32 v250, v122, v120, s51
    v_perm_b32 v251, v126, v124, s51
    s_nop 1
    v_mfma_f32_16x16x32_bf16 v[212:215], v[240:243], v[248:251], 0
    v_perm_b32 v244, v115, v113, s50
    v_perm_b32 v245, v119, v117, s50
    v_perm_b32 v246, v123, v121, s50
    v_perm_b32 v247, v127, v125, s50
    s_nop 1
    v_mfma_f32_16x16x32_bf16 v[216:219], v[240:243], v[244:247], 0
    v_perm_b32 v248, v115, v113, s51
    v_perm_b32 v249, v119, v117, s51
    v_perm_b32 v250, v123, v121, s51
    v_perm_b32 v251, v127, v125, s51
    s_nop 1
    v_mfma_f32_16x16x32_bf16 v[220:223], v[240:243], v[248:251], 0
    v_lshlrev_b32 v244, 4, v1
    v_add_u32 v244, s19, v244
    s_mov_b32 exec_lo, -1
    s_mov_b32 exec_hi, 0
    ds_write_b128 v244, v[176:179] offset:0
    ds_write_b128 v244, v[180:183] offset:512
    ds_write_b128 v244, v[184:187] offset:1024
    ds_write_b128 v244, v[188:191] offset:1536
    ds_write_b128 v244, v[192:195] offset:2048
    ds_write_b128 v244, v[196:199] offset:2560
    ds_write_b128 v244, v[200:203] offset:3072
    ds_write_b128 v244, v[204:207] offset:3584
    ds_write_b128 v244, v[208:211] offset:4096
    ds_write_b128 v244, v[212:215] offset:4608
    ds_write_b128 v244, v[216:219] offset:5120
    ds_write_b128 v244, v[220:223] offset:5632
    ds_write_b128 v244, v[224:227] offset:6144
    s_mov_b64 exec, -1
    s_cmp_ge_u32 s18, 4
    s_cbranch_scc1 L_noq1
    s_add_u32 m0, s101, 0
    s_nop 0
    buffer_load_dwordx4 v128, s[36:39], s48 offen offset:0 nt lds
    buffer_load_dwordx4 v129, s[36:39], s48 offen offset:1024 nt lds
    buffer_load_dwordx4 v130, s[36:39], s48 offen offset:2048 nt lds
    buffer_load_dwordx4 v131, s[36:39], s48 offen offset:3072 nt lds
    s_add_u32 m0, s101, 4096
    s_nop 0
    buffer_load_dwordx4 v132, s[36:39], s99 offen offset:0 nt lds
    buffer_load_dwordx4 v133, s[36:39], s99 offen offset:1024 nt lds
    s_add_u32 m0, s101, 6144
    s_nop 0
    buffer_load_dwordx4 v128, s[36:39], s49 offen offset:0 nt lds
    buffer_load_dwordx4 v129, s[36:39], s49 offen offset:1024 nt lds
    buffer_load_dwordx4 v130, s[36:39], s49 offen offset:2048 nt lds
    buffer_load_dwordx4 v131, s[36:39], s49 offen offset:3072 nt lds
    s_add_u32 m0, s101, 10240
    s_nop 0
    buffer_load_dwordx4 v132, s[36:39], s100 offen offset:0 nt lds
    buffer_load_dwordx4 v133, s[36:39], s100 offen offset:1024 nt lds
L_noq1:
    s_setprio 3
    v_min_u32 v249, 415, v0
    v_lshlrev_b32 v248, 4, v249
    v_add_u32 v250, 6784, v248
    v_mov_b32 v244, 6656
    s_waitcnt lgkmcnt(0)
    s_barrier
    ds_read_b32 v239, v244
    ds_read_b128 v[176:179], v250 offset:0
    ds_read_b128 v[180:183], v250 offset:6656
    ds_read_b128 v[184:187], v250 offset:13312
    ds_read_b128 v[188:191], v250 offset:19968
    ds_read_b128 v[192:195], v250 offset:26624
    ds_read_b128 v[196:199], v250 offset:33280
    ds_read_b128 v[200:203], v250 offset:39936
    ds_read_b128 v[204:207], v250 offset:46592
    s_waitcnt lgkmcnt(6)
    v_add_f32 v176, v176, v180
    v_add_f32 v177, v177, v181
    v_add_f32 v178, v178, v182
    v_add_f32 v179, v179, v183
    s_waitcnt lgkmcnt(5)
    v_add_f32 v176, v176, v184
    v_add_f32 v177, v177, v185
    v_add_f32 v178, v178, v186
    v_add_f32 v179, v179, v187
    s_waitcnt lgkmcnt(4)
    v_add_f32 v176, v176, v188
    v_add_f32 v177, v177, v189
    v_add_f32 v178, v178, v190
    v_add_f32 v179, v179, v191
    s_waitcnt lgkmcnt(3)
    v_add_f32 v176, v176, v192
    v_add_f32 v177, v177, v193
    v_add_f32 v178, v178, v194
    v_add_f32 v179, v179, v195
    s_waitcnt lgkmcnt(2)
    v_add_f32 v176, v176, v196
    v_add_f32 v177, v177, v197
    v_add_f32 v178, v178, v198
    v_add_f32 v179, v179, v199
    s_waitcnt lgkmcnt(1)
    v_add_f32 v176, v176, v200
    v_add_f32 v177, v177, v201
    v_add_f32 v178, v178, v202
    v_add_f32 v179, v179, v203
    s_waitcnt lgkmcnt(0)
    v_add_f32 v176, v176, v204
    v_add_f32 v177, v177, v205
    v_add_f32 v178, v178, v206
    v_add_f32 v179, v179, v207
    v_bfi_b32 v176, s61, v176, v239
    v_bfi_b32 v177, s61, v177, v239
    v_bfi_b32 v178, s61, v178, v239
    v_bfi_b32 v179, s61, v179, v239
    buffer_store_dwordx4 v[176:179], v248, s[32:35], s55 offen sc1
    v_mov_b32 v246, v239
    s_cmp_lt_u32 s18, 4
    s_cbranch_scc1 L_early
    s_add_u32 m0, s101, 0
    s_nop 0
    buffer_load_dwordx4 v128, s[36:39], s48 offen offset:0 nt lds
    buffer_load_dwordx4 v129, s[36:39], s48 offen offset:1024 nt lds
    buffer_load_dwordx4 v130, s[36:39], s48 offen offset:2048 nt lds
    buffer_load_dwordx4 v131, s[36:39], s48 offen offset:3072 nt lds
    s_add_u32 m0, s101, 4096
    s_nop 0
    buffer_load_dwordx4 v132, s[36:39], s99 offen offset:0 nt lds
    buffer_load_dwordx4 v133, s[36:39], s99 offen offset:1024 nt lds
    s_add_u32 m0, s101, 6144
    s_nop 0
    buffer_load_dwordx4 v128, s[36:39], s49 offen offset:0 nt lds
    buffer_load_dwordx4 v129, s[36:39], s49 offen offset:1024 nt lds
    buffer_load_dwordx4 v130, s[36:39], s49 offen offset:2048 nt lds
    buffer_load_dwordx4 v131, s[36:39], s49 offen offset:3072 nt lds
    s_add_u32 m0, s101, 10240
    s_nop 0
    buffer_load_dwordx4 v132, s[36:39], s100 offen offset:0 nt lds
    buffer_load_dwordx4 v133, s[36:39], s100 offen offset:1024 nt lds
    v_lshrrev_b32 v107, 5, v249
    v_and_b32 v108, 15, v249
    v_bfe_u32 v109, v249, 4, 1
    v_lshl_add_u32 v110, v108, 3, v107
    v_lshl_add_u32 v111, v108, 2, v107
    v_add_u32 v111, 120, v111
    v_cmp_gt_u32 vcc, 8, v107
    s_nop 1
    v_cndmask_b32 v110, v111, v110, vcc
    v_lshrrev_b32 v111, 5, v110
    v_bfe_u32 v112, v110, 2, 1
    v_lshl_add_u32 v111, v111, 1, v112
    v_bfe_u32 v112, v110, 3, 2
    v_and_b32 v113, 3, v110
    v_lshl_add_u32 v112, v112, 2, v113
    v_cmp_eq_u32 vcc, 12, v107
    s_nop 1
    v_cndmask_b32 v111, v111, v107, vcc
    v_cndmask_b32 v112, v112, v108, vcc
    v_lshl_add_u32 v112, v109, 4, v112
    v_lshlrev_b32 v112, 3, v112
    v_lshl_add_u32 v106, v111, 9, v112
    s_waitcnt vmcnt(12)
    s_branch L_pbar
L_early:
    v_lshrrev_b32 v107, 5, v249
    v_and_b32 v108, 15, v249
    v_bfe_u32 v109, v249, 4, 1
    v_lshl_add_u32 v110, v108, 3, v107
    v_lshl_add_u32 v111, v108, 2, v107
    v_add_u32 v111, 120, v111
    v_cmp_gt_u32 vcc, 8, v107
    s_nop 1
    v_cndmask_b32 v110, v111, v110, vcc
    v_lshrrev_b32 v111, 5, v110
    v_bfe_u32 v112, v110, 2, 1
    v_lshl_add_u32 v111, v111, 1, v112
    v_bfe_u32 v112, v110, 3, 2
    v_and_b32 v113, 3, v110
    v_lshl_add_u32 v112, v112, 2, v113
    v_cmp_eq_u32 vcc, 12, v107
    s_nop 1
    v_cndmask_b32 v111, v111, v107, vcc
    v_cndmask_b32 v112, v112, v108, vcc
    v_lshl_add_u32 v112, v109, 4, v112
    v_lshlrev_b32 v112, 3, v112
    v_lshl_add_u32 v106, v111, 9, v112
    s_waitcnt vmcnt(1)
L_qproj:
    ds_read_b128 v[32:35], v2 offset:0
    ds_read_b128 v[36:39], v5 offset:0
    ds_read_b128 v[40:43], v2 offset:128
    ds_read_b128 v[44:47], v5 offset:128
    ds_read_b128 v[48:51], v2 offset:256
    ds_read_b128 v[52:55], v5 offset:256
    ds_read_b128 v[56:59], v2 offset:6144
    ds_read_b128 v[60:63], v5 offset:6144
    ds_read_b128 v[64:67], v2 offset:6272
    ds_read_b128 v[68:71], v5 offset:6272
    ds_read_b128 v[72:75], v2 offset:6400
    ds_read_b128 v[76:79], v5 offset:6400
    s_waitcnt lgkmcnt(6)
    v_mov_b32 v236, 0
    v_mov_b32 v237, 0
    v_mfma_f32_16x16x32_bf16 v[228:231], v[8:11], v[32:35], 0
    v_dot2c_f32_bf16 v236, v32, v32
    v_dot2c_f32_bf16 v237, v33, v33
    v_dot2c_f32_bf16 v236, v34, v34
    v_dot2c_f32_bf16 v237, v35, v35
    v_mfma_f32_16x16x32_bf16 v[228:231], v[12:15], v[36:39], v[228:231]
    v_dot2c_f32_bf16 v236, v36, v36
    v_dot2c_f32_bf16 v237, v37, v37
    v_dot2c_f32_bf16 v236, v38, v38
    v_dot2c_f32_bf16 v237, v39, v39
    v_mfma_f32_16x16x32_bf16 v[228:231], v[16:19], v[40:43], v[228:231]
    v_dot2c_f32_bf16 v236, v40, v40
    v_dot2c_f32_bf16 v237, v41, v41
    v_dot2c_f32_bf16 v236, v42, v42
    v_dot2c_f32_bf16 v237, v43, v43
    v_mfma_f32_16x16x32_bf16 v[228:231], v[20:23], v[44:47], v[228:231]
    v_dot2c_f32_bf16 v236, v44, v44
    v_dot2c_f32_bf16 v237, v45, v45
    v_dot2c_f32_bf16 v236, v46, v46
    v_dot2c_f32_bf16 v237, v47, v47
    v_mfma_f32_16x16x32_bf16 v[228:231], v[24:27], v[48:51], v[228:231]
    v_dot2c_f32_bf16 v236, v48, v48
    v_dot2c_f32_bf16 v237, v49, v49
    v_dot2c_f32_bf16 v236, v50, v50
    v_dot2c_f32_bf16 v237, v51, v51
    v_mfma_f32_16x16x32_bf16 v[228:231], v[28:31], v[52:55], v[228:231]
    v_dot2c_f32_bf16 v236, v52, v52
    v_dot2c_f32_bf16 v237, v53, v53
    v_dot2c_f32_bf16 v236, v54, v54
    v_dot2c_f32_bf16 v237, v55, v55
    s_nop 2
    v_add_f32 v236, v236, v237
    s_nop 1
    v_mfma_f32_16x16x4_f32 v[228:231], v6, v236, v[228:231]
    s_nop 9
    v_fma_f32 v228, v228, s52, v7
    v_fma_f32 v229, v229, s52, v7
    v_fma_f32 v230, v230, s52, v7
    v_fma_f32 v231, v231, s52, v7
    v_exp_f32 v228, v228
    v_exp_f32 v229, v229
    v_exp_f32 v230, v230
    v_exp_f32 v231, v231
    v_add_f32 v228, 0x358637bd, v228
    v_add_f32 v229, 0x358637bd, v229
    v_add_f32 v230, 0x358637bd, v230
    v_add_f32 v231, 0x358637bd, v231
    v_cvt_pk_bf16_f32 v240, v228, v229
    v_cvt_pk_bf16_f32 v241, v230, v231
    s_waitcnt lgkmcnt(0)
    v_mov_b32 v238, 0
    v_mov_b32 v239, 0
    v_mfma_f32_16x16x32_bf16 v[232:235], v[8:11], v[56:59], 0
    v_dot2c_f32_bf16 v238, v56, v56
    v_dot2c_f32_bf16 v239, v57, v57
    v_dot2c_f32_bf16 v238, v58, v58
    v_dot2c_f32_bf16 v239, v59, v59
    v_mfma_f32_16x16x32_bf16 v[232:235], v[12:15], v[60:63], v[232:235]
    v_dot2c_f32_bf16 v238, v60, v60
    v_dot2c_f32_bf16 v239, v61, v61
    v_dot2c_f32_bf16 v238, v62, v62
    v_dot2c_f32_bf16 v239, v63, v63
    v_mfma_f32_16x16x32_bf16 v[232:235], v[16:19], v[64:67], v[232:235]
    v_dot2c_f32_bf16 v238, v64, v64
    v_dot2c_f32_bf16 v239, v65, v65
    v_dot2c_f32_bf16 v238, v66, v66
    v_dot2c_f32_bf16 v239, v67, v67
    v_mfma_f32_16x16x32_bf16 v[232:235], v[20:23], v[68:71], v[232:235]
    v_dot2c_f32_bf16 v238, v68, v68
    v_dot2c_f32_bf16 v239, v69, v69
    v_dot2c_f32_bf16 v238, v70, v70
    v_dot2c_f32_bf16 v239, v71, v71
    v_mfma_f32_16x16x32_bf16 v[232:235], v[24:27], v[72:75], v[232:235]
    v_dot2c_f32_bf16 v238, v72, v72
    v_dot2c_f32_bf16 v239, v73, v73
    v_dot2c_f32_bf16 v238, v74, v74
    v_dot2c_f32_bf16 v239, v75, v75
    v_mfma_f32_16x16x32_bf16 v[232:235], v[28:31], v[76:79], v[232:235]
    v_dot2c_f32_bf16 v238, v76, v76
    v_dot2c_f32_bf16 v239, v77, v77
    v_dot2c_f32_bf16 v238, v78, v78
    v_dot2c_f32_bf16 v239, v79, v79
    s_nop 2
    v_add_f32 v238, v238, v239
    s_nop 1
    v_mfma_f32_16x16x4_f32 v[232:235], v6, v238, v[232:235]
    s_nop 9
    v_fma_f32 v232, v232, s52, v7
    v_fma_f32 v233, v233, s52, v7
    v_fma_f32 v234, v234, s52, v7
    v_fma_f32 v235, v235, s52, v7
    v_exp_f32 v232, v232
    v_exp_f32 v233, v233
    v_exp_f32 v234, v234
    v_exp_f32 v235, v235
    v_add_f32 v232, 0x358637bd, v232
    v_add_f32 v233, 0x358637bd, v233
    v_add_f32 v234, 0x358637bd, v234
    v_add_f32 v235, 0x358637bd, v235
    v_cvt_pk_bf16_f32 v242, v232, v233
    v_cvt_pk_bf16_f32 v243, v234, v235
    s_cmp_ge_u32 s18, 4
    s_cbranch_scc1 L_out
    s_waitcnt vmcnt(0)
L_pbar:
    s_barrier
    s_mov_b32 s59, 0x4000
    s_mov_b32 s58, 0
    s_cmp_eq_u32 s18, 7
    s_cbranch_scc1 L_skip7
L_retry:
    s_mov_b32 s57, s56
    buffer_load_dwordx4 v[180:183], v248, s[32:35], s57 offen sc1
    s_add_u32 s57, s57, 6656
    buffer_load_dwordx4 v[184:187], v248, s[32:35], s57 offen sc1
    s_add_u32 s57, s57, 6656
    buffer_load_dwordx4 v[188:191], v248, s[32:35], s57 offen sc1
    s_add_u32 s57, s57, 6656
    buffer_load_dwordx4 v[192:195], v248, s[32:35], s57 offen sc1
    s_add_u32 s57, s57, 6656
    buffer_load_dwordx4 v[196:199], v248, s[32:35], s57 offen sc1
    s_add_u32 s57, s57, 6656
    buffer_load_dwordx4 v[200:203], v248, s[32:35], s57 offen sc1
    s_add_u32 s57, s57, 6656
    buffer_load_dwordx4 v[204:207], v248, s[32:35], s57 offen sc1
    s_add_u32 s57, s57, 6656
    buffer_load_dwordx4 v[208:211], v248, s[32:35], s57 offen sc1
    s_waitcnt vmcnt(7)
    v_xor_b32 v180, v180, v246
    v_xor_b32 v181, v181, v246
    v_xor_b32 v182, v182, v246
    v_xor_b32 v183, v183, v246
    v_or3_b32 v212, v180, v181, v182
    v_or_b32 v212, v212, v183
    s_waitcnt vmcnt(6)
    v_xor_b32 v184, v184, v246
    v_xor_b32 v185, v185, v246
    v_xor_b32 v186, v186, v246
    v_xor_b32 v187, v187, v246
    v_or3_b32 v212, v212, v184, v185
    v_or3_b32 v212, v212, v186, v187
    v_add_f32 v176, v180, v184
    v_add_f32 v177, v181, v185
    v_add_f32 v178, v182, v186
    v_add_f32 v179, v183, v187
    s_waitcnt vmcnt(5)
    v_xor_b32 v188, v188, v246
    v_xor_b32 v189, v189, v246
    v_xor_b32 v190, v190, v246
    v_xor_b32 v191, v191, v246
    v_or3_b32 v212, v212, v188, v189
    v_or3_b32 v212, v212, v190, v191
    v_add_f32 v176, v176, v188
    v_add_f32 v177, v177, v189
    v_add_f32 v178, v178, v190
    v_add_f32 v179, v179, v191
    s_waitcnt vmcnt(4)
    v_xor_b32 v192, v192, v246
    v_xor_b32 v193, v193, v246
    v_xor_b32 v194, v194, v246
    v_xor_b32 v195, v195, v246
    v_or3_b32 v212, v212, v192, v193
    v_or3_b32 v212, v212, v194, v195
    v_add_f32 v176, v176, v192
    v_add_f32 v177, v177, v193
    v_add_f32 v178, v178, v194
    v_add_f32 v179, v179, v195
    s_waitcnt vmcnt(3)
    v_xor_b32 v196, v196, v246
    v_xor_b32 v197, v197, v246
    v_xor_b32 v198, v198, v246
    v_xor_b32 v199, v199, v246
    v_or3_b32 v212, v212, v196, v197
    v_or3_b32 v212, v212, v198, v199
    v_add_f32 v176, v176, v196
    v_add_f32 v177, v177, v197
    v_add_f32 v178, v178, v198
    v_add_f32 v179, v179, v199
    s_waitcnt vmcnt(2)
    v_xor_b32 v200, v200, v246
    v_xor_b32 v201, v201, v246
    v_xor_b32 v202, v202, v246
    v_xor_b32 v203, v203, v246
    v_or3_b32 v212, v212, v200, v201
    v_or3_b32 v212, v212, v202, v203
    v_add_f32 v176, v176, v200
    v_add_f32 v177, v177, v201
    v_add_f32 v178, v178, v202
    v_add_f32 v179, v179, v203
    s_waitcnt vmcnt(1)
    v_xor_b32 v204, v204, v246
    v_xor_b32 v205, v205, v246
    v_xor_b32 v206, v206, v246
    v_xor_b32 v207, v207, v246
    v_or3_b32 v212, v212, v204, v205
    v_or3_b32 v212, v212, v206, v207
    v_add_f32 v176, v176, v204
    v_add_f32 v177, v177, v205
    v_add_f32 v178, v178, v206
    v_add_f32 v179, v179, v207
    s_waitcnt vmcnt(0)
    v_xor_b32 v208, v208, v246
    v_xor_b32 v209, v209, v246
    v_xor_b32 v210, v210, v246
    v_xor_b32 v211, v211, v246
    v_or3_b32 v212, v212, v208, v209
    v_or3_b32 v212, v212, v210, v211
    v_add_f32 v176, v176, v208
    v_add_f32 v177, v177, v209
    v_add_f32 v178, v178, v210
    v_add_f32 v179, v179, v211
    v_and_b32 v212, 0xfff, v212
    v_cmp_ne_u32 s[62:63], 0, v212
    s_sub_u32 s59, s59, 1
    s_cmp_eq_u32 s59, 0
    s_cbranch_scc1 L_got
    s_cmp_lg_u64 s[62:63], 0
    s_cbranch_scc1 L_retry
L_got:
    v_cvt_pk_bf16_f32 v184, v176, v177
    v_cvt_pk_bf16_f32 v185, v178, v179
    v_lshlrev_b32 v188, 16, v184
    v_and_b32 v189, 0xffff0000, v184
    v_lshlrev_b32 v190, 16, v185
    v_and_b32 v191, 0xffff0000, v185
    v_sub_f32 v188, v176, v188
    v_sub_f32 v189, v177, v189
    v_sub_f32 v190, v178, v190
    v_sub_f32 v191, v179, v191
    v_cvt_pk_bf16_f32 v186, v188, v189
    v_cvt_pk_bf16_f32 v187, v190, v191
    ds_write_b64 v106, v[184:185] offset:0
    ds_write_b64 v106, v[186:187] offset:256
    s_waitcnt lgkmcnt(0)
    s_branch L_C
L_skip7:
    s_waitcnt vmcnt(0)
L_C:
    s_barrier
    v_lshlrev_b32 v244, 3, v1
    ds_read_b64 v[104:105], v244 offset:6144
    ds_read_b64 v[80:81], v244 offset:0
    ds_read_b64 v[82:83], v244 offset:512
    ds_read_b64 v[84:85], v244 offset:1024
    ds_read_b64 v[86:87], v244 offset:1536
    ds_read_b64 v[88:89], v244 offset:2048
    ds_read_b64 v[90:91], v244 offset:2560
    ds_read_b64 v[92:93], v244 offset:3072
    ds_read_b64 v[94:95], v244 offset:3584
    ds_read_b64 v[96:97], v244 offset:4096
    ds_read_b64 v[98:99], v244 offset:4608
    ds_read_b64 v[100:101], v244 offset:5120
    ds_read_b64 v[102:103], v244 offset:5632
    s_cmp_lt_u32 s18, 4
    s_cbranch_scc1 L_out
    s_setprio 0
    s_waitcnt vmcnt(0) lgkmcnt(0)
    s_branch L_qproj
L_out:
    v_lshlrev_b32 v134, 4, v1
    v_add_u32 v134, s101, v134
    s_waitcnt lgkmcnt(12)
    v_mfma_f32_16x16x16_bf16 v[224:227], v[104:105], v[240:241], 0
    s_waitcnt lgkmcnt(11)
    v_mfma_f32_16x16x16_bf16 v[176:179], v[80:81], v[240:241], 0
    s_waitcnt lgkmcnt(10)
    v_mfma_f32_16x16x16_bf16 v[180:183], v[82:83], v[240:241], 0
    s_waitcnt lgkmcnt(9)
    v_mfma_f32_16x16x16_bf16 v[184:187], v[84:85], v[240:241], 0
    s_waitcnt lgkmcnt(8)
    v_mfma_f32_16x16x16_bf16 v[188:191], v[86:87], v[240:241], 0
    s_waitcnt lgkmcnt(7)
    v_mfma_f32_16x16x16_bf16 v[192:195], v[88:89], v[240:241], 0
    s_waitcnt lgkmcnt(6)
    v_mfma_f32_16x16x16_bf16 v[196:199], v[90:91], v[240:241], 0
    s_waitcnt lgkmcnt(5)
    v_mfma_f32_16x16x16_bf16 v[200:203], v[92:93], v[240:241], 0
    s_waitcnt lgkmcnt(4)
    v_mfma_f32_16x16x16_bf16 v[204:207], v[94:95], v[240:241], 0
    s_waitcnt lgkmcnt(3)
    v_mfma_f32_16x16x16_bf16 v[208:211], v[96:97], v[240:241], 0
    s_waitcnt lgkmcnt(2)
    v_mfma_f32_16x16x16_bf16 v[212:215], v[98:99], v[240:241], 0
    s_waitcnt lgkmcnt(1)
    v_mfma_f32_16x16x16_bf16 v[216:219], v[100:101], v[240:241], 0
    s_waitcnt lgkmcnt(0)
    v_mfma_f32_16x16x16_bf16 v[220:223], v[102:103], v[240:241], 0
    v_add_f32 v224, 0x358637bd, v224
    v_rcp_f32 v224, v224
    s_nop 0
    v_mul_f32 v176, v176, v224
    v_mul_f32 v177, v177, v224
    v_mul_f32 v178, v178, v224
    v_mul_f32 v179, v179, v224
    v_mul_f32 v180, v180, v224
    v_mul_f32 v181, v181, v224
    v_mul_f32 v182, v182, v224
    v_mul_f32 v183, v183, v224
    v_cvt_pk_bf16_f32 v176, v176, v177
    v_cvt_pk_bf16_f32 v177, v178, v179
    v_cvt_pk_bf16_f32 v178, v180, v181
    v_cvt_pk_bf16_f32 v179, v182, v183
    ds_write_b128 v2, v[176:179] offset:0
    v_mul_f32 v184, v184, v224
    v_mul_f32 v185, v185, v224
    v_mul_f32 v186, v186, v224
    v_mul_f32 v187, v187, v224
    v_mul_f32 v188, v188, v224
    v_mul_f32 v189, v189, v224
    v_mul_f32 v190, v190, v224
    v_mul_f32 v191, v191, v224
    v_cvt_pk_bf16_f32 v184, v184, v185
    v_cvt_pk_bf16_f32 v185, v186, v187
    v_cvt_pk_bf16_f32 v186, v188, v189
    v_cvt_pk_bf16_f32 v187, v190, v191
    ds_write_b128 v5, v[184:187] offset:0
    v_mul_f32 v192, v192, v224
    v_mul_f32 v193, v193, v224
    v_mul_f32 v194, v194, v224
    v_mul_f32 v195, v195, v224
    v_mul_f32 v196, v196, v224
    v_mul_f32 v197, v197, v224
    v_mul_f32 v198, v198, v224
    v_mul_f32 v199, v199, v224
    v_cvt_pk_bf16_f32 v192, v192, v193
    v_cvt_pk_bf16_f32 v193, v194, v195
    v_cvt_pk_bf16_f32 v194, v196, v197
    v_cvt_pk_bf16_f32 v195, v198, v199
    ds_write_b128 v2, v[192:195] offset:128
    v_mul_f32 v200, v200, v224
    v_mul_f32 v201, v201, v224
    v_mul_f32 v202, v202, v224
    v_mul_f32 v203, v203, v224
    v_mul_f32 v204, v204, v224
    v_mul_f32 v205, v205, v224
    v_mul_f32 v206, v206, v224
    v_mul_f32 v207, v207, v224
    v_cvt_pk_bf16_f32 v200, v200, v201
    v_cvt_pk_bf16_f32 v201, v202, v203
    v_cvt_pk_bf16_f32 v202, v204, v205
    v_cvt_pk_bf16_f32 v203, v206, v207
    ds_write_b128 v5, v[200:203] offset:128
    v_mul_f32 v208, v208, v224
    v_mul_f32 v209, v209, v224
    v_mul_f32 v210, v210, v224
    v_mul_f32 v211, v211, v224
    v_mul_f32 v212, v212, v224
    v_mul_f32 v213, v213, v224
    v_mul_f32 v214, v214, v224
    v_mul_f32 v215, v215, v224
    v_cvt_pk_bf16_f32 v208, v208, v209
    v_cvt_pk_bf16_f32 v209, v210, v211
    v_cvt_pk_bf16_f32 v210, v212, v213
    v_cvt_pk_bf16_f32 v211, v214, v215
    ds_write_b128 v2, v[208:211] offset:256
    v_mul_f32 v216, v216, v224
    v_mul_f32 v217, v217, v224
    v_mul_f32 v218, v218, v224
    v_mul_f32 v219, v219, v224
    v_mul_f32 v220, v220, v224
    v_mul_f32 v221, v221, v224
    v_mul_f32 v222, v222, v224
    v_mul_f32 v223, v223, v224
    v_cvt_pk_bf16_f32 v216, v216, v217
    v_cvt_pk_bf16_f32 v217, v218, v219
    v_cvt_pk_bf16_f32 v218, v220, v221
    v_cvt_pk_bf16_f32 v219, v222, v223
    ds_write_b128 v5, v[216:219] offset:256
    s_waitcnt lgkmcnt(0)
    ds_read_b128 v[136:139], v134 offset:0
    ds_read_b128 v[140:143], v134 offset:1024
    ds_read_b128 v[144:147], v134 offset:2048
    ds_read_b128 v[148:151], v134 offset:3072
    ds_read_b128 v[152:155], v134 offset:4096
    ds_read_b128 v[156:159], v134 offset:5120
    s_waitcnt lgkmcnt(5)
    buffer_store_dwordx4 v[136:139], v128, s[40:43], s48 offen offset:0 sc1
    s_waitcnt lgkmcnt(4)
    buffer_store_dwordx4 v[140:143], v129, s[40:43], s48 offen offset:1024 sc1
    s_waitcnt lgkmcnt(3)
    buffer_store_dwordx4 v[144:147], v130, s[40:43], s48 offen offset:2048 sc1
    s_waitcnt lgkmcnt(2)
    buffer_store_dwordx4 v[148:151], v131, s[40:43], s48 offen offset:3072 sc1
    s_waitcnt lgkmcnt(1)
    buffer_store_dwordx4 v[152:155], v132, s[40:43], s99 offen offset:0 sc1
    s_waitcnt lgkmcnt(0)
    buffer_store_dwordx4 v[156:159], v133, s[40:43], s99 offen offset:1024 sc1
    v_mfma_f32_16x16x16_bf16 v[76:79], v[104:105], v[242:243], 0
    v_mfma_f32_16x16x16_bf16 v[28:31], v[80:81], v[242:243], 0
    v_mfma_f32_16x16x16_bf16 v[32:35], v[82:83], v[242:243], 0
    v_mfma_f32_16x16x16_bf16 v[36:39], v[84:85], v[242:243], 0
    v_mfma_f32_16x16x16_bf16 v[40:43], v[86:87], v[242:243], 0
    v_mfma_f32_16x16x16_bf16 v[44:47], v[88:89], v[242:243], 0
    v_mfma_f32_16x16x16_bf16 v[48:51], v[90:91], v[242:243], 0
    v_mfma_f32_16x16x16_bf16 v[52:55], v[92:93], v[242:243], 0
    v_mfma_f32_16x16x16_bf16 v[56:59], v[94:95], v[242:243], 0
    v_mfma_f32_16x16x16_bf16 v[60:63], v[96:97], v[242:243], 0
    v_mfma_f32_16x16x16_bf16 v[64:67], v[98:99], v[242:243], 0
    v_mfma_f32_16x16x16_bf16 v[68:71], v[100:101], v[242:243], 0
    v_mfma_f32_16x16x16_bf16 v[72:75], v[102:103], v[242:243], 0
    v_add_f32 v76, 0x358637bd, v76
    v_rcp_f32 v76, v76
    s_nop 0
    v_mul_f32 v28, v28, v76
    v_mul_f32 v29, v29, v76
    v_mul_f32 v30, v30, v76
    v_mul_f32 v31, v31, v76
    v_mul_f32 v32, v32, v76
    v_mul_f32 v33, v33, v76
    v_mul_f32 v34, v34, v76
    v_mul_f32 v35, v35, v76
    v_cvt_pk_bf16_f32 v28, v28, v29
    v_cvt_pk_bf16_f32 v29, v30, v31
    v_cvt_pk_bf16_f32 v30, v32, v33
    v_cvt_pk_bf16_f32 v31, v34, v35
    ds_write_b128 v2, v[28:31] offset:6144
    v_mul_f32 v36, v36, v76
    v_mul_f32 v37, v37, v76
    v_mul_f32 v38, v38, v76
    v_mul_f32 v39, v39, v76
    v_mul_f32 v40, v40, v76
    v_mul_f32 v41, v41, v76
    v_mul_f32 v42, v42, v76
    v_mul_f32 v43, v43, v76
    v_cvt_pk_bf16_f32 v36, v36, v37
    v_cvt_pk_bf16_f32 v37, v38, v39
    v_cvt_pk_bf16_f32 v38, v40, v41
    v_cvt_pk_bf16_f32 v39, v42, v43
    ds_write_b128 v5, v[36:39] offset:6144
    v_mul_f32 v44, v44, v76
    v_mul_f32 v45, v45, v76
    v_mul_f32 v46, v46, v76
    v_mul_f32 v47, v47, v76
    v_mul_f32 v48, v48, v76
    v_mul_f32 v49, v49, v76
    v_mul_f32 v50, v50, v76
    v_mul_f32 v51, v51, v76
    v_cvt_pk_bf16_f32 v44, v44, v45
    v_cvt_pk_bf16_f32 v45, v46, v47
    v_cvt_pk_bf16_f32 v46, v48, v49
    v_cvt_pk_bf16_f32 v47, v50, v51
    ds_write_b128 v2, v[44:47] offset:6272
    v_mul_f32 v52, v52, v76
    v_mul_f32 v53, v53, v76
    v_mul_f32 v54, v54, v76
    v_mul_f32 v55, v55, v76
    v_mul_f32 v56, v56, v76
    v_mul_f32 v57, v57, v76
    v_mul_f32 v58, v58, v76
    v_mul_f32 v59, v59, v76
    v_cvt_pk_bf16_f32 v52, v52, v53
    v_cvt_pk_bf16_f32 v53, v54, v55
    v_cvt_pk_bf16_f32 v54, v56, v57
    v_cvt_pk_bf16_f32 v55, v58, v59
    ds_write_b128 v5, v[52:55] offset:6272
    v_mul_f32 v60, v60, v76
    v_mul_f32 v61, v61, v76
    v_mul_f32 v62, v62, v76
    v_mul_f32 v63, v63, v76
    v_mul_f32 v64, v64, v76
    v_mul_f32 v65, v65, v76
    v_mul_f32 v66, v66, v76
    v_mul_f32 v67, v67, v76
    v_cvt_pk_bf16_f32 v60, v60, v61
    v_cvt_pk_bf16_f32 v61, v62, v63
    v_cvt_pk_bf16_f32 v62, v64, v65
    v_cvt_pk_bf16_f32 v63, v66, v67
    ds_write_b128 v2, v[60:63] offset:6400
    v_mul_f32 v68, v68, v76
    v_mul_f32 v69, v69, v76
    v_mul_f32 v70, v70, v76
    v_mul_f32 v71, v71, v76
    v_mul_f32 v72, v72, v76
    v_mul_f32 v73, v73, v76
    v_mul_f32 v74, v74, v76
    v_mul_f32 v75, v75, v76
    v_cvt_pk_bf16_f32 v68, v68, v69
    v_cvt_pk_bf16_f32 v69, v70, v71
    v_cvt_pk_bf16_f32 v70, v72, v73
    v_cvt_pk_bf16_f32 v71, v74, v75
    ds_write_b128 v5, v[68:71] offset:6400
    s_waitcnt lgkmcnt(0)
    ds_read_b128 v[176:179], v134 offset:6144
    ds_read_b128 v[180:183], v134 offset:7168
    ds_read_b128 v[184:187], v134 offset:8192
    ds_read_b128 v[188:191], v134 offset:9216
    ds_read_b128 v[192:195], v134 offset:10240
    ds_read_b128 v[196:199], v134 offset:11264
    s_waitcnt lgkmcnt(5)
    buffer_store_dwordx4 v[176:179], v128, s[40:43], s49 offen offset:0 sc1
    s_waitcnt lgkmcnt(4)
    buffer_store_dwordx4 v[180:183], v129, s[40:43], s49 offen offset:1024 sc1
    s_waitcnt lgkmcnt(3)
    buffer_store_dwordx4 v[184:187], v130, s[40:43], s49 offen offset:2048 sc1
    s_waitcnt lgkmcnt(2)
    buffer_store_dwordx4 v[188:191], v131, s[40:43], s49 offen offset:3072 sc1
    s_waitcnt lgkmcnt(1)
    buffer_store_dwordx4 v[192:195], v132, s[40:43], s100 offen offset:0 sc1
    s_waitcnt lgkmcnt(0)
    buffer_store_dwordx4 v[196:199], v133, s[40:43], s100 offen offset:1024 sc1
L_end:
    s_endpgm
.section .rodata,"a"
.p2align 6
.amdhsa_kernel standalone__linear_kernel_rfa__prompt_kernel
  .amdhsa_next_free_vgpr 256
  .amdhsa_next_free_sgpr 102
  .amdhsa_accum_offset 256
  .amdhsa_group_segment_fixed_size 0
  .amdhsa_kernarg_size 56
  .amdhsa_user_sgpr_count 2
  .amdhsa_user_sgpr_kernarg_segment_ptr 1
  .amdhsa_system_sgpr_workgroup_id_x 1
.end_amdhsa_kernel
```
